```python
import torch

def _softmax(x, axis=-1):
    return torch.softmax(x, dim=axis)
def _gelu(x):
    return torch.nn.functional.gelu(x, approximate="tanh")
def _silu(x):
    return torch.nn.functional.silu(x)
def _sigmoid(x):
    return torch.sigmoid(x)
def _layernorm(x, axis=-1, eps=1e-5):
    m = x.mean(dim=axis, keepdim=True)
    v = x.var(dim=axis, keepdim=True, unbiased=False)
    return (x - m) / torch.sqrt(v + eps)
def _scatter_add(tgt, idx, src, axis=0):
    return tgt.clone().index_add_(axis, idx, src)
def _segment_sum(src, seg, n):
    out = torch.zeros((n,) + src.shape[1:], dtype=src.dtype)
    return out.index_add_(0, seg, src)
def _pad(x, pw):
    flat = tuple(v for pair in reversed(pw) for v in pair)
    return torch.nn.functional.pad(x, flat)

kernel_name = 'concat_heads__gqa_block_cached__sliding_block_cached__decode'

def setup_inputs():

    _w = (lambda a: (lambda t: t.to(torch.bfloat16) if t.is_floating_point() else t)(torch.as_tensor(a)))
    def _A_setup():
        B, Sq, D = 1, 1, 448
        Hq, Hkv, Sk, Dh = 16, 8, 8192, 256
        assert Hq % Hkv == 0, (Hq, Hkv)
        return {
            "x": _w((lambda *s: torch.randn(*s, dtype=torch.bfloat16) * 0.8)(B, Sq, D)),
            "k_cache": _w((lambda *s: torch.randn(*s, dtype=torch.bfloat16) * 1.6)(B, Hkv, Sk, Dh)),
            "v_cache": _w((lambda *s: torch.randn(*s, dtype=torch.bfloat16) * 0.2)(B, Hkv, Sk, Dh)),
            "wq": _w((lambda *s: torch.randn(*s, dtype=torch.bfloat16) * 1.6)(D, Hq * Dh) * (D ** -0.5)),
            "wo": _w((lambda *s: torch.randn(*s, dtype=torch.bfloat16) * 0.2)(Hq * Dh, D) * ((Hq * Dh) ** -0.5)),
        }
    _A_in = _A_setup()

    def _B_setup():
        B, Sq, D = 1, 1, 448
        Hq, Hkv, Sk, Dh = 16, 8, 8192, 256
        assert Hq % Hkv == 0, (Hq, Hkv)
        return {
            "x": _w((lambda *s: torch.randn(*s, dtype=torch.bfloat16) * 0.8)(B, Sq, D)),
            "k_cache": _w((lambda *s: torch.randn(*s, dtype=torch.bfloat16) * 1.6)(B, Hkv, Sk, Dh)),
            "v_cache": _w((lambda *s: torch.randn(*s, dtype=torch.bfloat16) * 0.2)(B, Hkv, Sk, Dh)),
            "wq": _w((lambda *s: torch.randn(*s, dtype=torch.bfloat16) * 1.6)(D, Hq * Dh) * (D ** -0.5)),
            "wo": _w((lambda *s: torch.randn(*s, dtype=torch.bfloat16) * 0.2)(Hq * Dh, D) * ((Hq * Dh) ** -0.5)),
        }
    _B_in = _B_setup()

    return {
        "A_x": _A_in["x"],
        "A_k_cache": _A_in["k_cache"],
        "A_v_cache": _A_in["v_cache"],
        "A_wq": _A_in["wq"],
        "A_wo": _A_in["wo"],
        "B_x": _B_in["x"],
        "B_k_cache": _B_in["k_cache"],
        "B_v_cache": _B_in["v_cache"],
        "B_wq": _B_in["wq"],
        "B_wo": _B_in["wo"],
    }

def reference(A_x, A_k_cache, A_v_cache, A_wq, A_wo, B_x, B_k_cache, B_v_cache, B_wq, B_wo):
    def _A_ref(x, k_cache, v_cache, wq, wo):
        B, Sq, D = x.shape
        Hq, Dh = 16, 256
        Hkv = k_cache.shape[1]
        rep = Hq // Hkv
        q = (lambda x, *d: x.permute(*d))((x @ wq).reshape(B, Sq, Hq, Dh), 0, 2, 1, 3)
        k = (lambda x, n, axis: torch.repeat_interleave(x, n, dim=axis))(k_cache, rep, axis=1)
        v = (lambda x, n, axis: torch.repeat_interleave(x, n, dim=axis))(v_cache, rep, axis=1)
        scores = torch.einsum("bhqd,bhkd->bhqk", q, k) * (Dh ** -0.5)
        p = _softmax(scores, axis=-1)
        o = torch.einsum("bhqk,bhkd->bhqd", p, v)
        return (lambda x, *d: x.permute(*d))(o, 0, 2, 1, 3).reshape(B, Sq, Hq * Dh) @ wo

    def _B_ref(x, k_cache, v_cache, wq, wo):
        B, Sq, D = x.shape
        Hq, Dh = 16, 256
        Hkv, Sk = k_cache.shape[1], k_cache.shape[2]
        W = min(4096, max(256, Sk // 4))
        rep = Hq // Hkv
        q = (lambda x, *d: x.permute(*d))((x @ wq).reshape(B, Sq, Hq, Dh), 0, 2, 1, 3)
        k = (lambda x, n, axis: torch.repeat_interleave(x, n, dim=axis))(k_cache[:, :, Sk - W:, :], rep, axis=1)
        v = (lambda x, n, axis: torch.repeat_interleave(x, n, dim=axis))(v_cache[:, :, Sk - W:, :], rep, axis=1)
        scores = torch.einsum("bhqd,bhkd->bhqk", q, k) * (Dh ** -0.5)
        p = _softmax(scores, axis=-1)
        o = torch.einsum("bhqk,bhkd->bhqd", p, v)
        return (lambda x, *d: x.permute(*d))(o, 0, 2, 1, 3).reshape(B, Sq, Hq * Dh) @ wo

    a = _A_ref(A_x, A_k_cache, A_v_cache, A_wq, A_wo)
    b = _B_ref(B_x, B_k_cache, B_v_cache, B_wq, B_wo)
    return torch.concatenate([a, b], axis=-1)
```

```asm
; @launch grid=(256,1,1) block=(768,1,1) lds=53248
.amdgcn_target "amdgcn-amd-amdhsa--gfx950"
.text
.globl concat_heads__gqa_block_cached__sliding_block_cached__decode_kernel
.p2align 8
.type concat_heads__gqa_block_cached__sliding_block_cached__decode_kernel,@function
concat_heads__gqa_block_cached__sliding_block_cached__decode_kernel:
    s_load_dwordx16 s[4:19], s[0:1], 0
    s_load_dwordx8 s[20:27], s[0:1], 64
    s_load_dwordx2 s[28:29], s[0:1], 96
    v_lshrrev_b32 v1, 6, v0
    s_lshr_b32 s48, s2, 3
    v_readfirstlane_b32 s30, v1
    s_cmp_ge_u32 s48, 32
    s_cbranch_scc1 L_end
    v_and_b32 v0, 63, v0
    s_and_b32 s31, s2, 7
    s_sub_u32 s58, s30, 4
    s_cmp_gt_u32 s58, 6
    s_cbranch_scc1 L_other
    s_and_b32 s90, s2, 1
    s_cselect_b32 s53, 3, 5
    s_cselect_b32 s54, 35, 0
    v_lshrrev_b32 v3, 3, v0
    v_and_b32 v13, 7, v0
    s_mul_i32 s55, s53, s58
    v_mul_u32_u24 v9, s53, v3
    s_add_u32 s54, s54, s55
    v_lshlrev_b32 v8, 13, v9
    s_lshr_b32 s92, s31, 1
    s_add_u32 s92, s92, s48
    s_and_b32 s92, s92, 3
    s_and_b32 s56, s48, 15
    s_lshl2_add_u32 s92, s56, s92
    v_lshl_add_u32 v8, v13, 4, v8
    s_lshl_b32 s55, s54, 16
    s_lshl_b32 s56, s92, 7
    s_add_u32 s55, s55, s56
    s_mov_b32 s34, 3670016
    s_mov_b32 s35, 0x20000
    s_movk_i32 s59, 0x2000
    s_lshr_b32 s52, s48, 4
    s_waitcnt lgkmcnt(0)
    s_cselect_b32 s32, s20, s10
    s_cselect_b32 s33, s21, s11
    s_cselect_b32 s36, s14, s4
    s_cselect_b32 s37, s15, s5
    buffer_load_dwordx4 v[40:43], v8, s[32:35], s55 offen nt
    s_add_u32 s55, s55, s59
    buffer_load_dwordx4 v[44:47], v8, s[32:35], s55 offen nt
    s_add_u32 s55, s55, s59
    buffer_load_dwordx4 v[48:51], v8, s[32:35], s55 offen nt
    s_add_u32 s55, s55, s59
    s_cmp_lg_u32 s90, 0
    s_cselect_b32 s34, 0, s34
    buffer_load_dwordx4 v[52:55], v8, s[32:35], s55 offen nt
    s_add_u32 s55, s55, s59
    buffer_load_dwordx4 v[56:59], v8, s[32:35], s55 offen nt
    s_movk_i32 s38, 896
    s_mov_b32 s39, s35
    v_lshlrev_b32 v3, 1, v0
    s_lshl_b32 s56, s54, 4
    buffer_load_ushort v31, v3, s[36:39], s56 offen
    v_mov_b32 v10, 0
    v_mov_b32 v11, 0
    v_lshlrev_b32 v15, 3, v0
    v_mov_b32 v18, 0xff800000
    v_lshlrev_b32 v14, 2, v0
    ds_write_b64 v15, v[10:11] offset:2048
    ds_write_b32 v14, v18 offset:2560
    s_waitcnt lgkmcnt(0)
    s_barrier
    v_and_b32 v16, 3, v0
    v_lshlrev_b32 v16, 4, v16
    v_mov_b32 v18, 0xffff
    v_mov_b32 v19, 0
    v_lshlrev_b64 v[18:19], v16, v[18:19]
    v_bfe_i32 v16, v0, 2, 1
    v_and_b32 v6, v18, v16
    v_and_b32 v7, v19, v16
    v_xor_b32 v4, v18, v6
    v_xor_b32 v5, v19, v7
    s_lshl_b32 s55, s58, 9
    s_add_u32 s55, s55, 4096
    v_lshl_add_u32 v14, v0, 3, s55
    s_lshl_b32 s55, s58, 2
    v_mov_b32 v15, s55
    v_mov_b32 v12, 1
    v_lshlrev_b32 v9, 2, v9
    s_waitcnt vmcnt(0)
    v_lshl_or_b32 v31, v31, 16, v31
    ds_bpermute_b32 v24, v9, v31 offset:0
    ds_bpermute_b32 v25, v9, v31 offset:4
    ds_bpermute_b32 v26, v9, v31 offset:8
    ds_bpermute_b32 v27, v9, v31 offset:12
    ds_bpermute_b32 v28, v9, v31 offset:16
    s_waitcnt lgkmcnt(0)
    v_and_b32 v72, v24, v4
    v_and_b32 v73, v24, v5
    v_and_b32 v74, v24, v6
    v_and_b32 v75, v24, v7
    v_and_b32 v76, v25, v4
    v_and_b32 v77, v25, v5
    v_and_b32 v78, v25, v6
    v_and_b32 v79, v25, v7
    v_and_b32 v80, v26, v4
    v_and_b32 v81, v26, v5
    v_and_b32 v82, v26, v6
    v_and_b32 v83, v26, v7
    v_and_b32 v84, v27, v4
    v_and_b32 v85, v27, v5
    v_and_b32 v86, v27, v6
    v_and_b32 v87, v27, v7
    v_and_b32 v88, v28, v4
    v_and_b32 v89, v28, v5
    v_and_b32 v90, v28, v6
    v_and_b32 v91, v28, v7
    s_nop 0
    v_mfma_f32_16x16x32_bf16 v[20:23], v[72:75], v[40:43], 0
    v_mfma_f32_16x16x32_bf16 v[20:23], v[76:79], v[44:47], v[20:23]
    v_mfma_f32_16x16x32_bf16 v[20:23], v[80:83], v[48:51], v[20:23]
    v_mfma_f32_16x16x32_bf16 v[20:23], v[84:87], v[52:55], v[20:23]
    v_mfma_f32_16x16x32_bf16 v[20:23], v[88:91], v[56:59], v[20:23]
    s_nop 7
    v_mov_b32_dpp v20, v20 row_ror:8 row_mask:0xc bank_mask:0xf
    v_mov_b32_dpp v21, v21 row_ror:8 row_mask:0xc bank_mask:0xf
    v_mov_b32_dpp v22, v22 row_ror:8 row_mask:0xc bank_mask:0xf
    v_mov_b32_dpp v23, v23 row_ror:8 row_mask:0xc bank_mask:0xf
    s_nop 0
    v_permlane32_swap_b32 v20, v22
    v_permlane32_swap_b32 v21, v23
    v_add_f32 v16, v20, v22
    v_add_f32 v17, v21, v23
    ds_write_b64 v14, v[16:17]
    ds_write_b32 v15, v12 offset:2068
    s_branch L_kv
L_other:
    s_sub_u32 s57, s30, 1
    s_cmp_gt_u32 s57, 2
    s_cbranch_scc0 L_kv
    s_waitcnt lgkmcnt(0)
    s_load_dword s50, s[28:29], 0
    s_barrier
    s_cmp_eq_u32 s30, 0
    s_cbranch_scc1 L_helper
    s_branch L_wo
L_kv:
    s_sub_u32 s57, s30, 1
    s_mul_i32 s49, s48, 10
    s_add_u32 s49, s49, s57
    s_lshr_b32 s3, s48, 0
    v_lshrrev_b32 v1, 4, v0
    v_and_b32 v2, 15, v0
    v_bfrev_b32 v8, v0
    v_lshrrev_b32 v8, 29, v8
    v_lshlrev_b32 v8, 9, v8
    v_lshl_add_u32 v8, v1, 4, v8
    v_bfe_u32 v9, v0, 3, 1
    v_lshl_add_u32 v8, v9, 6, v8
    s_mov_b32 s34, 0x2000000
    s_mov_b32 s35, 0x20000
    v_lshlrev_b32 v9, 4, v2
    v_lshl_add_u32 v9, v1, 9, v9
    s_mov_b32 s38, s34
    s_mov_b32 s39, s35
    s_lshr_b32 s52, s49, 8
    s_waitcnt lgkmcnt(0)
    s_cselect_b32 s32, s16, s6
    s_cselect_b32 s33, s17, s7
    s_cselect_b32 s36, s18, s8
    s_cselect_b32 s37, s19, s9
    s_cselect_b32 s53, 64, 0
    s_sub_u32 s49, s49, s53
    s_lshl_b32 s53, s31, 8
    s_add_u32 s49, s49, s53
    s_lshl_b32 s49, s49, 14
    s_add_u32 s54, s49, 4096
    s_add_u32 s44, s49, 8192
    s_add_u32 s55, s49, 12288
    v_lshlrev_b32 v3, 2, v2
    s_lshl_b32 s53, s57, 2
    v_mov_b32 v11, s53
    s_cmp_gt_u32 s30, 3
    s_cbranch_scc1 L_gated
    s_barrier
L_kiss:
    buffer_load_dwordx4 v[40:43], v8, s[32:35], s49 offen offset:0 nt
    buffer_load_dwordx4 v[44:47], v8, s[32:35], s49 offen offset:128 nt
    buffer_load_dwordx4 v[48:51], v8, s[32:35], s49 offen offset:256 nt
    buffer_load_dwordx4 v[52:55], v8, s[32:35], s49 offen offset:384 nt
    buffer_load_dwordx4 v[56:59], v8, s[32:35], s54 offen offset:0 nt
    buffer_load_dwordx4 v[60:63], v8, s[32:35], s54 offen offset:128 nt
    buffer_load_dwordx4 v[64:67], v8, s[32:35], s54 offen offset:256 nt
    buffer_load_dwordx4 v[68:71], v8, s[32:35], s54 offen offset:384 nt
    buffer_load_dwordx4 v[72:75], v8, s[32:35], s44 offen offset:0 nt
    buffer_load_dwordx4 v[76:79], v8, s[32:35], s44 offen offset:128 nt
    buffer_load_dwordx4 v[80:83], v8, s[32:35], s44 offen offset:256 nt
    buffer_load_dwordx4 v[84:87], v8, s[32:35], s44 offen offset:384 nt
    buffer_load_dwordx4 v[88:91], v8, s[32:35], s55 offen offset:0 nt
    buffer_load_dwordx4 v[92:95], v8, s[32:35], s55 offen offset:128 nt
    buffer_load_dwordx4 v[96:99], v8, s[32:35], s55 offen offset:256 nt
    buffer_load_dwordx4 v[100:103], v8, s[32:35], s55 offen offset:384 nt
    v_mov_b32 v16, 1
    ds_write_b32 v11, v16 offset:2096
    s_cmp_gt_u32 s30, 3
    s_cbranch_scc1 L_kw
    v_and_b32 v16, 3, v0
    v_lshlrev_b32 v16, 4, v16
    v_mov_b32 v18, 0xffff
    v_mov_b32 v19, 0
    v_lshlrev_b64 v[18:19], v16, v[18:19]
    v_bfe_i32 v16, v0, 2, 1
    v_and_b32 v6, v18, v16
    v_and_b32 v7, v19, v16
    v_xor_b32 v4, v18, v6
    v_xor_b32 v5, v19, v7
L_kw:
    s_mov_b32 s66, 8000000
L_w1:
    ds_read_b32 v16, v3 offset:2096
    s_waitcnt lgkmcnt(0)
    v_cmp_ne_u32 vcc, 0, v16
    s_and_b32 s69, vcc_lo, 1023
    s_cmp_eq_u32 s69, 1023
    s_cbranch_scc1 L_w1_ok
    s_sleep 1
    s_sub_u32 s66, s66, 1
    s_cmp_lg_u32 s66, 0
    s_cbranch_scc1 L_w1
    s_branch L_end
L_w1_ok:
    s_branch L_viss
L_gated:
    s_mov_b32 s66, 8000000
L_w2:
    ds_read_b32 v16, v3 offset:2064
    s_waitcnt lgkmcnt(0)
    v_cmp_ne_u32 vcc, 0, v16
    s_and_b32 s69, vcc_lo, 1
    s_cmp_eq_u32 s69, 1
    s_cbranch_scc1 L_w2_ok
    s_sleep 1
    s_sub_u32 s66, s66, 1
    s_cmp_lg_u32 s66, 0
    s_cbranch_scc1 L_w2
    s_branch L_end
L_w2_ok:
    s_branch L_kiss
L_viss:
    buffer_load_dwordx4 v[104:107], v9, s[36:39], s49 offen offset:0 nt
    buffer_load_dwordx4 v[108:111], v9, s[36:39], s49 offen offset:256 nt
    buffer_load_dwordx4 v[112:115], v9, s[36:39], s49 offen offset:2048 nt
    buffer_load_dwordx4 v[116:119], v9, s[36:39], s49 offen offset:2304 nt
    buffer_load_dwordx4 v[120:123], v9, s[36:39], s54 offen offset:0 nt
    buffer_load_dwordx4 v[124:127], v9, s[36:39], s54 offen offset:256 nt
    buffer_load_dwordx4 v[128:131], v9, s[36:39], s54 offen offset:2048 nt
    buffer_load_dwordx4 v[132:135], v9, s[36:39], s54 offen offset:2304 nt
    buffer_load_dwordx4 v[136:139], v9, s[36:39], s44 offen offset:0 nt
    buffer_load_dwordx4 v[140:143], v9, s[36:39], s44 offen offset:256 nt
    buffer_load_dwordx4 v[144:147], v9, s[36:39], s44 offen offset:2048 nt
    buffer_load_dwordx4 v[148:151], v9, s[36:39], s44 offen offset:2304 nt
    buffer_load_dwordx4 v[152:155], v9, s[36:39], s55 offen offset:0 nt
    buffer_load_dwordx4 v[156:159], v9, s[36:39], s55 offen offset:256 nt
    buffer_load_dwordx4 v[160:163], v9, s[36:39], s55 offen offset:2048 nt
    buffer_load_dwordx4 v[164:167], v9, s[36:39], s55 offen offset:2304 nt
    v_mov_b32 v16, 1
    ds_write_b32 v11, v16 offset:2136
L_nov:
    s_mov_b32 s40, s28
    s_mov_b32 s41, s29
    s_mov_b32 s42, 0x10000000
    s_mov_b32 s43, 0x20000
    s_and_b32 s67, s48, 15
    s_lshl4_add_u32 s67, s31, s67
    s_lshl_b32 s67, s67, 5
    s_lshr_b32 s69, s48, 4
    s_mul_i32 s69, s69, 229376
    s_add_u32 s67, s67, s69
    s_lshl_b32 s69, s57, 15
    s_add_u32 s67, s67, s69
    s_add_u32 s67, s67, 1048576
    v_and_b32 v13, 1, v1
    v_lshrrev_b32 v15, 5, v0
    v_lshrrev_b32 v14, 3, v2
    s_lshl_b32 s53, s52, 10
    v_lshlrev_b32 v10, 9, v14
    v_lshl_add_u32 v10, v1, 4, v10
    v_add_u32 v10, s53, v10
    v_and_b32 v12, 1, v0
    v_lshl_add_u32 v10, v12, 6, v10
    s_lshl_b32 s53, s52, 7
    v_lshl_add_u32 v8, v14, 6, s53
    v_add_u32 v8, v8, v11
    v_lshlrev_b32 v12, 10, v15
    v_lshl_add_u32 v15, v15, 6, s53
    s_lshl_b32 s53, s57, 11
    s_add_u32 s53, s53, 4096
    v_lshl_add_u32 v12, v2, 5, v12
    v_lshl_add_u32 v12, v13, 4, v12
    v_add_u32 v12, s53, v12
    s_cmp_ge_u32 s48, 26
    s_cselect_b32 s58, 1, 0
    s_cmp_ge_u32 s57, 2
    s_cselect_b32 s58, 1, s58
    s_add_u32 s59, s48, s58
    v_lshlrev_b32 v14, 4, v0
    s_and_b32 s60, s57, 1
    s_lshl_b32 s60, s60, 10
    s_add_u32 s60, s60, 4096
    v_add_u32 v13, s60, v14
    s_mul_i32 s64, s31, 40
    s_add_u32 s64, s64, s59
    s_lshl_b32 s64, s64, 11
    s_add_u32 s65, s60, s64
    s_add_u32 s65, s65, 126976
    s_mov_b32 s56, 0x3db8aa3b
    s_mov_b32 s66, 8000000
L_w3:
    ds_read_b32 v16, v3 offset:2048
    s_waitcnt lgkmcnt(0)
    v_cmp_ne_u32 vcc, 0, v16
    s_and_b32 s69, vcc_lo, 1
    s_cmp_eq_u32 s69, 1
    s_cbranch_scc1 L_w3_ok
    s_sleep 2
    s_sub_u32 s66, s66, 1
    s_cmp_lg_u32 s66, 0
    s_cbranch_scc1 L_w3
    s_branch L_end
L_w3_ok:
    v_readlane_b32 s50, v16, 1
    v_readlane_b32 s88, v16, 2
    ds_read_b128 v[16:19], v10 offset:0
    ds_read_b128 v[20:23], v10 offset:128
    ds_read_b128 v[24:27], v10 offset:256
    ds_read_b128 v[28:31], v10 offset:384
    s_and_b32 s86, s50, 0xff
    s_xor_b32 s87, s86, 0xa5
    s_waitcnt vmcnt(24) lgkmcnt(0)
    v_mfma_f32_16x16x32_bf16 v[32:35], v[40:43], v[16:19], 0
    v_mfma_f32_16x16x32_bf16 v[32:35], v[44:47], v[20:23], v[32:35]
    v_mfma_f32_16x16x32_bf16 v[32:35], v[48:51], v[24:27], v[32:35]
    v_mfma_f32_16x16x32_bf16 v[32:35], v[52:55], v[28:31], v[32:35]
    v_mfma_f32_16x16x32_bf16 v[36:39], v[56:59], v[16:19], 0
    v_mfma_f32_16x16x32_bf16 v[36:39], v[60:63], v[20:23], v[36:39]
    v_mfma_f32_16x16x32_bf16 v[36:39], v[64:67], v[24:27], v[36:39]
    v_mfma_f32_16x16x32_bf16 v[36:39], v[68:71], v[28:31], v[36:39]
    s_waitcnt vmcnt(16)
    v_mfma_f32_16x16x32_bf16 v[40:43], v[72:75], v[16:19], 0
    v_mfma_f32_16x16x32_bf16 v[40:43], v[76:79], v[20:23], v[40:43]
    v_mfma_f32_16x16x32_bf16 v[40:43], v[80:83], v[24:27], v[40:43]
    v_mfma_f32_16x16x32_bf16 v[40:43], v[84:87], v[28:31], v[40:43]
    v_mfma_f32_16x16x32_bf16 v[44:47], v[88:91], v[16:19], 0
    v_mfma_f32_16x16x32_bf16 v[44:47], v[92:95], v[20:23], v[44:47]
    v_mfma_f32_16x16x32_bf16 v[44:47], v[96:99], v[24:27], v[44:47]
    v_mfma_f32_16x16x32_bf16 v[44:47], v[100:103], v[28:31], v[44:47]
    v_permlane32_swap_b32 v32, v34
    v_permlane32_swap_b32 v33, v35
    v_permlane32_swap_b32 v36, v38
    v_permlane32_swap_b32 v37, v39
    v_mov_b32_dpp v34, v34 quad_perm:[1,1,3,3] row_mask:0xf bank_mask:0xf
    v_mov_b32_dpp v35, v35 quad_perm:[1,1,3,3] row_mask:0xf bank_mask:0xf
    v_mov_b32_dpp v38, v38 quad_perm:[1,1,3,3] row_mask:0xf bank_mask:0xf
    v_mov_b32_dpp v39, v39 quad_perm:[1,1,3,3] row_mask:0xf bank_mask:0xf
    v_add_f32_dpp v32, v32, v34 quad_perm:[0,0,2,2] row_mask:0xf bank_mask:0xf
    v_add_f32_dpp v33, v33, v35 quad_perm:[0,0,2,2] row_mask:0xf bank_mask:0xf
    v_add_f32_dpp v36, v36, v38 quad_perm:[0,0,2,2] row_mask:0xf bank_mask:0xf
    v_add_f32_dpp v37, v37, v39 quad_perm:[0,0,2,2] row_mask:0xf bank_mask:0xf
    v_permlane32_swap_b32 v40, v42
    v_permlane32_swap_b32 v41, v43
    v_permlane32_swap_b32 v44, v46
    v_permlane32_swap_b32 v45, v47
    v_mov_b32_dpp v42, v42 quad_perm:[1,1,3,3] row_mask:0xf bank_mask:0xf
    v_mov_b32_dpp v43, v43 quad_perm:[1,1,3,3] row_mask:0xf bank_mask:0xf
    v_mov_b32_dpp v46, v46 quad_perm:[1,1,3,3] row_mask:0xf bank_mask:0xf
    v_mov_b32_dpp v47, v47 quad_perm:[1,1,3,3] row_mask:0xf bank_mask:0xf
    v_add_f32_dpp v40, v40, v42 quad_perm:[0,0,2,2] row_mask:0xf bank_mask:0xf
    v_add_f32_dpp v41, v41, v43 quad_perm:[0,0,2,2] row_mask:0xf bank_mask:0xf
    v_add_f32_dpp v44, v44, v46 quad_perm:[0,0,2,2] row_mask:0xf bank_mask:0xf
    v_add_f32_dpp v45, v45, v47 quad_perm:[0,0,2,2] row_mask:0xf bank_mask:0xf
    v_cvt_pk_bf16_f32 v24, v32, v33
    v_cvt_pk_bf16_f32 v25, v36, v37
    v_cvt_pk_bf16_f32 v26, v40, v41
    v_cvt_pk_bf16_f32 v27, v44, v45
    v_lshlrev_b32 v16, 16, v24
    v_and_b32 v17, 0xffff0000, v24
    v_lshlrev_b32 v18, 16, v25
    v_and_b32 v19, 0xffff0000, v25
    v_lshlrev_b32 v20, 16, v26
    v_and_b32 v21, 0xffff0000, v26
    v_lshlrev_b32 v22, 16, v27
    v_and_b32 v23, 0xffff0000, v27
    v_max3_f32 v24, v16, v17, v18
    v_max3_f32 v25, v19, v20, v21
    v_max3_f32 v24, v24, v22, v23
    v_max_f32 v24, v24, v25
    v_mov_b32 v25, v24
    s_nop 1
    v_permlane32_swap_b32 v24, v25
    v_max_f32 v24, v24, v25
    v_mov_b32 v25, v24
    s_nop 1
    v_permlane16_swap_b32 v24, v25
    v_max_f32 v24, v24, v25
    v_mul_f32 v25, s56, v24
    v_fma_f32 v16, v16, s56, -v25
    v_fma_f32 v17, v17, s56, -v25
    v_fma_f32 v18, v18, s56, -v25
    v_fma_f32 v19, v19, s56, -v25
    v_fma_f32 v20, v20, s56, -v25
    v_fma_f32 v21, v21, s56, -v25
    v_fma_f32 v22, v22, s56, -v25
    v_fma_f32 v23, v23, s56, -v25
    v_exp_f32 v16, v16
    v_exp_f32 v17, v17
    v_exp_f32 v18, v18
    v_exp_f32 v19, v19
    v_exp_f32 v20, v20
    v_exp_f32 v21, v21
    v_exp_f32 v22, v22
    v_exp_f32 v23, v23
    s_nop 0
    v_add_f32 v28, v16, v17
    v_add_f32 v25, v18, v19
    v_add_f32 v26, v20, v21
    v_add_f32 v27, v22, v23
    v_add_f32 v28, v28, v25
    v_add_f32 v26, v26, v27
    v_add_f32 v28, v28, v26
    v_mov_b32 v25, v28
    s_nop 1
    v_permlane32_swap_b32 v28, v25
    v_add_f32 v28, v28, v25
    v_mov_b32 v25, v28
    s_nop 1
    v_permlane16_swap_b32 v28, v25
    v_add_f32 v28, v28, v25
    v_mov_b32 v25, 1
    s_mov_b64 exec, 0x0101
    ds_write_b32 v8, v24 offset:2560
    ds_write_b32 v8, v28 offset:2304
    ds_write_b32 v11, v25 offset:2176
    s_mov_b64 exec, -1
    v_cvt_pk_bf16_f32 v16, v16, v16
    v_cvt_pk_bf16_f32 v17, v17, v17
    v_cvt_pk_bf16_f32 v18, v18, v18
    v_cvt_pk_bf16_f32 v19, v19, v19
    v_cvt_pk_bf16_f32 v20, v20, v20
    v_cvt_pk_bf16_f32 v21, v21, v21
    v_cvt_pk_bf16_f32 v22, v22, v22
    v_cvt_pk_bf16_f32 v23, v23, v23
    v_and_b32 v40, v16, v4
    v_and_b32 v41, v16, v5
    v_and_b32 v42, v16, v6
    v_and_b32 v43, v16, v7
    v_and_b32 v44, v17, v4
    v_and_b32 v45, v17, v5
    v_and_b32 v46, v17, v6
    v_and_b32 v47, v17, v7
    v_and_b32 v48, v18, v4
    v_and_b32 v49, v18, v5
    v_and_b32 v50, v18, v6
    v_and_b32 v51, v18, v7
    v_and_b32 v52, v19, v4
    v_and_b32 v53, v19, v5
    v_and_b32 v54, v19, v6
    v_and_b32 v55, v19, v7
    v_and_b32 v56, v20, v4
    v_and_b32 v57, v20, v5
    v_and_b32 v58, v20, v6
    v_and_b32 v59, v20, v7
    v_and_b32 v60, v21, v4
    v_and_b32 v61, v21, v5
    v_and_b32 v62, v21, v6
    v_and_b32 v63, v21, v7
    v_and_b32 v64, v22, v4
    v_and_b32 v65, v22, v5
    v_and_b32 v66, v22, v6
    v_and_b32 v67, v22, v7
    v_and_b32 v68, v23, v4
    v_and_b32 v69, v23, v5
    v_and_b32 v70, v23, v6
    v_and_b32 v71, v23, v7
    s_waitcnt vmcnt(14)
    v_mfma_f32_16x16x32_bf16 v[32:35], v[40:43], v[104:107], 0
    v_mfma_f32_16x16x32_bf16 v[36:39], v[40:43], v[108:111], 0
    s_waitcnt vmcnt(12)
    v_mfma_f32_16x16x32_bf16 v[32:35], v[44:47], v[112:115], v[32:35]
    v_mfma_f32_16x16x32_bf16 v[36:39], v[44:47], v[116:119], v[36:39]
    s_waitcnt vmcnt(10)
    v_mfma_f32_16x16x32_bf16 v[32:35], v[48:51], v[120:123], v[32:35]
    v_mfma_f32_16x16x32_bf16 v[36:39], v[48:51], v[124:127], v[36:39]
    s_waitcnt vmcnt(8)
    v_mfma_f32_16x16x32_bf16 v[32:35], v[52:55], v[128:131], v[32:35]
    v_mfma_f32_16x16x32_bf16 v[36:39], v[52:55], v[132:135], v[36:39]
    s_waitcnt vmcnt(6)
    v_mfma_f32_16x16x32_bf16 v[32:35], v[56:59], v[136:139], v[32:35]
    v_mfma_f32_16x16x32_bf16 v[36:39], v[56:59], v[140:143], v[36:39]
    s_waitcnt vmcnt(4)
    v_mfma_f32_16x16x32_bf16 v[32:35], v[60:63], v[144:147], v[32:35]
    v_mfma_f32_16x16x32_bf16 v[36:39], v[60:63], v[148:151], v[36:39]
    s_mov_b32 s66, 8000000
L_w4:
    ds_read_b32 v16, v3 offset:2176
    s_waitcnt lgkmcnt(0)
    v_cmp_ne_u32 vcc, 0, v16
    s_and_b32 s69, vcc_lo, 1023
    s_cmp_eq_u32 s69, 1023
    s_cbranch_scc1 L_w4_ok
    s_sleep 1
    s_sub_u32 s66, s66, 1
    s_cmp_lg_u32 s66, 0
    s_cbranch_scc1 L_w4
    s_branch L_end
L_w4_ok:
    v_add_u32 v28, v15, v11
    ds_read_b128 v[16:19], v15 offset:2560
    ds_read_b128 v[20:23], v15 offset:2576
    ds_read_b64 v[24:25], v15 offset:2592
    ds_read_b32 v26, v28 offset:2560
    s_waitcnt lgkmcnt(0)
    v_max3_f32 v16, v16, v17, v18
    v_max3_f32 v19, v19, v20, v21
    v_max3_f32 v22, v22, v23, v24
    v_max3_f32 v16, v16, v19, v25
    v_max_f32 v16, v16, v22
    v_sub_f32 v26, v26, v16
    v_mul_f32 v26, s56, v26
    v_exp_f32 v26, v26
    v_mov_b32 v30, 0xff
    v_mov_b32 v25, 1
    v_mov_b32 v27, v26
    s_waitcnt vmcnt(2)
    v_mfma_f32_16x16x32_bf16 v[32:35], v[64:67], v[152:155], v[32:35]
    v_mfma_f32_16x16x32_bf16 v[36:39], v[64:67], v[156:159], v[36:39]
    s_waitcnt vmcnt(0)
    v_mfma_f32_16x16x32_bf16 v[32:35], v[68:71], v[160:163], v[32:35]
    v_mfma_f32_16x16x32_bf16 v[36:39], v[68:71], v[164:167], v[36:39]
    s_nop 6
    v_pk_mul_f32 v[32:33], v[32:33], v[26:27]
    v_pk_mul_f32 v[34:35], v[34:35], v[26:27]
    ds_write_b128 v12, v[32:35]
    v_pk_mul_f32 v[36:37], v[36:37], v[26:27]
    v_pk_mul_f32 v[38:39], v[38:39], v[26:27]
    ds_write_b128 v12, v[36:39] offset:512
    ds_write_b32 v11, v25 offset:2216
    s_cmp_ge_u32 s57, 7
    s_cbranch_scc1 L_end
    s_cmp_eq_u32 s3, 25
    s_cbranch_scc1 L_pub_str
    s_cmp_lt_u32 s57, 2
    s_cbranch_scc0 L_kv_done
    s_mov_b32 s66, 8000000
L_w5:
    ds_read_b32 v20, v3 offset:2216
    s_waitcnt lgkmcnt(0)
    v_cmp_ne_u32 vcc, 0, v20
    s_and_b32 s69, vcc_lo, 127
    s_cmp_eq_u32 s69, 127
    s_cbranch_scc1 L_w5_ok
    s_sub_u32 s66, s66, 1
    s_cmp_lg_u32 s66, 0
    s_cbranch_scc1 L_w5
    s_branch L_end
L_w5_ok:
    ds_read_b128 v[40:43], v13 offset:0
    ds_read_b128 v[44:47], v13 offset:2048
    ds_read_b128 v[48:51], v13 offset:4096
    ds_read_b128 v[52:55], v13 offset:6144
    ds_read_b128 v[56:59], v13 offset:8192
    ds_read_b128 v[60:63], v13 offset:10240
    ds_read_b128 v[64:67], v13 offset:12288
    s_waitcnt lgkmcnt(5)
    v_pk_add_f32 v[40:41], v[40:41], v[44:45]
    v_pk_add_f32 v[42:43], v[42:43], v[46:47]
    s_waitcnt lgkmcnt(3)
    v_pk_add_f32 v[48:49], v[48:49], v[52:53]
    v_pk_add_f32 v[50:51], v[50:51], v[54:55]
    s_waitcnt lgkmcnt(1)
    v_pk_add_f32 v[56:57], v[56:57], v[60:61]
    v_pk_add_f32 v[58:59], v[58:59], v[62:63]
    s_waitcnt lgkmcnt(0)
    v_pk_add_f32 v[40:41], v[40:41], v[48:49]
    v_pk_add_f32 v[42:43], v[42:43], v[50:51]
    v_pk_add_f32 v[56:57], v[56:57], v[64:65]
    v_pk_add_f32 v[58:59], v[58:59], v[66:67]
    v_pk_add_f32 v[40:41], v[40:41], v[56:57]
    v_pk_add_f32 v[42:43], v[42:43], v[58:59]
L_pub2:
    s_mov_b32 s66, 8000000
L_w6:
    ds_read_b32 v20, v3 offset:2216
    s_waitcnt lgkmcnt(0)
    v_cmp_ne_u32 vcc, 0, v20
    s_and_b32 s69, vcc_lo, 1023
    s_cmp_eq_u32 s69, 1023
    s_cbranch_scc1 L_w6_ok
    s_sub_u32 s66, s66, 1
    s_cmp_lg_u32 s66, 0
    s_cbranch_scc1 L_w6
    s_branch L_end
L_w6_ok:
    ds_read_b128 v[44:47], v13 offset:14336
    ds_read_b128 v[48:51], v13 offset:16384
    ds_read_b128 v[52:55], v13 offset:18432
    s_waitcnt lgkmcnt(2)
    v_pk_add_f32 v[40:41], v[40:41], v[44:45]
    v_pk_add_f32 v[42:43], v[42:43], v[46:47]
    s_waitcnt lgkmcnt(0)
    v_pk_add_f32 v[48:49], v[48:49], v[52:53]
    v_pk_add_f32 v[50:51], v[50:51], v[54:55]
    v_pk_add_f32 v[40:41], v[40:41], v[48:49]
    v_pk_add_f32 v[42:43], v[42:43], v[50:51]
L_pub3:
    v_bfi_b32 v40, v30, s86, v40
    v_bfi_b32 v42, v30, s87, v42
    s_cmp_eq_u32 s88, 0
    s_cbranch_scc1 L_p7_s
    buffer_store_dwordx4 v[40:43], v14, s[40:43], s65 offen
    s_branch L_p7_e
L_p7_s:
    buffer_store_dwordx4 v[40:43], v14, s[40:43], s65 offen sc1
L_p7_e:
L_kv_done:
    v_and_b32 v12, 7, v0
    v_lshlrev_b32 v9, 12, v12
    v_and_b32 v13, 1, v1
    v_lshl_add_u32 v9, v13, 4, v9
    v_lshrrev_b32 v15, 5, v0
    v_lshl_add_u32 v9, v15, 3, v9
    v_mul_u32_u24 v28, 0xa5, v15
    v_xor_b32 v28, s86, v28
    s_mov_b32 s60, 0x00ff00ff
    s_mov_b32 s61, s60
    v_lshrrev_b32 v15, 3, v0
    v_lshlrev_b32 v15, 4, v15
    s_lshl_b32 s53, s57, 12
    s_add_u32 s53, s53, 24576
    v_add_u32 v29, s53, v14
    s_barrier
    ds_read_b128 v[20:23], v15 offset:2816
    ds_read_b128 v[72:75], v29 offset:0
    ds_read_b128 v[76:79], v29 offset:1024
    ds_read_b128 v[80:83], v29 offset:2048
    ds_read_b128 v[84:87], v29 offset:3072
    s_waitcnt lgkmcnt(4)
    v_and_b32 v48, v20, v4
    v_and_b32 v49, v20, v5
    v_and_b32 v50, v20, v6
    v_and_b32 v51, v20, v7
    v_and_b32 v52, v21, v4
    v_and_b32 v53, v21, v5
    v_and_b32 v54, v21, v6
    v_and_b32 v55, v21, v7
    s_waitcnt lgkmcnt(0)
    v_mfma_f32_16x16x32_bf16 v[32:35], v[48:51], v[72:75], 0
    v_and_b32 v56, v22, v4
    v_and_b32 v57, v22, v5
    v_and_b32 v58, v22, v6
    v_and_b32 v59, v22, v7
    v_mfma_f32_16x16x32_bf16 v[32:35], v[52:55], v[76:79], v[32:35]
    v_and_b32 v60, v23, v4
    v_and_b32 v61, v23, v5
    v_and_b32 v62, v23, v6
    v_and_b32 v63, v23, v7
    v_mfma_f32_16x16x32_bf16 v[32:35], v[56:59], v[80:83], v[32:35]
    s_nop 0
    v_mfma_f32_16x16x32_bf16 v[32:35], v[60:63], v[84:87], v[32:35]
    s_nop 7
    v_mov_b32_dpp v32, v32 row_ror:8 row_mask:0xc bank_mask:0xf
    v_mov_b32_dpp v33, v33 row_ror:8 row_mask:0xc bank_mask:0xf
    v_mov_b32_dpp v34, v34 row_ror:8 row_mask:0xc bank_mask:0xf
    v_mov_b32_dpp v35, v35 row_ror:8 row_mask:0xc bank_mask:0xf
    s_nop 0
    v_permlane32_swap_b32 v32, v34
    v_permlane32_swap_b32 v33, v35
    v_add_f32 v24, v32, v34
    v_add_f32 v25, v33, v35
    v_bfi_b32 v24, v30, v28, v24
    s_mov_b64 exec, s[60:61]
    buffer_store_dwordx2 v[24:25], v9, s[40:43], s67 offen sc1
    s_endpgm
L_pub_str:
    s_cmp_lt_u32 s57, 2
    s_cbranch_scc0 L_pub_str2
    s_mov_b32 s66, 8000000
L_w8:
    ds_read_b32 v20, v3 offset:2216
    s_waitcnt lgkmcnt(0)
    v_cmp_ne_u32 vcc, 0, v20
    s_and_b32 s69, vcc_lo, 63
    s_cmp_eq_u32 s69, 63
    s_cbranch_scc1 L_w8_ok
    s_sub_u32 s66, s66, 1
    s_cmp_lg_u32 s66, 0
    s_cbranch_scc1 L_w8
    s_branch L_end
L_w8_ok:
    ds_read_b128 v[40:43], v13 offset:0
    ds_read_b128 v[44:47], v13 offset:2048
    ds_read_b128 v[48:51], v13 offset:4096
    ds_read_b128 v[52:55], v13 offset:6144
    ds_read_b128 v[56:59], v13 offset:8192
    ds_read_b128 v[60:63], v13 offset:10240
    s_waitcnt lgkmcnt(4)
    v_pk_add_f32 v[40:41], v[40:41], v[44:45]
    v_pk_add_f32 v[42:43], v[42:43], v[46:47]
    s_waitcnt lgkmcnt(2)
    v_pk_add_f32 v[48:49], v[48:49], v[52:53]
    v_pk_add_f32 v[50:51], v[50:51], v[54:55]
    s_waitcnt lgkmcnt(0)
    v_pk_add_f32 v[56:57], v[56:57], v[60:61]
    v_pk_add_f32 v[58:59], v[58:59], v[62:63]
    v_pk_add_f32 v[40:41], v[40:41], v[48:49]
    v_pk_add_f32 v[42:43], v[42:43], v[50:51]
    v_pk_add_f32 v[40:41], v[40:41], v[56:57]
    v_pk_add_f32 v[42:43], v[42:43], v[58:59]
    s_branch L_pub3
L_pub_str2:
    s_cmp_lt_u32 s57, 4
    s_cbranch_scc0 L_kv_done
    s_mov_b32 s66, 8000000
L_w9:
    ds_read_b32 v20, v3 offset:2216
    s_waitcnt lgkmcnt(0)
    v_cmp_ne_u32 vcc, 0, v20
    s_and_b32 s69, vcc_lo, 127
    s_cmp_eq_u32 s69, 127
    s_cbranch_scc1 L_w9_ok
    s_sub_u32 s66, s66, 1
    s_cmp_lg_u32 s66, 0
    s_cbranch_scc1 L_w9
    s_branch L_end
L_w9_ok:
    ds_read_b128 v[40:43], v13 offset:12288
    s_waitcnt lgkmcnt(0)
    s_branch L_pub2
L_wo:
    v_mov_b32 v10, 0
    s_waitcnt lgkmcnt(0)
    s_mov_b32 s40, s28
    s_mov_b32 s41, s29
    s_mov_b32 s42, 0x10000000
    s_mov_b32 s43, 0x20000
    v_lshrrev_b32 v3, 3, v0
    v_and_b32 v13, 7, v0
    v_mul_u32_u24 v8, 3584, v3
    v_lshl_add_u32 v8, v13, 4, v8
    v_and_b32 v3, 15, v0
    v_lshlrev_b32 v3, 2, v3
    s_cmp_lt_u32 s48, 16
    s_cselect_b32 s44, s12, s22
    s_cselect_b32 s45, s13, s23
    s_mov_b32 s46, 3670016
    s_mov_b32 s47, 0x20000
    s_and_b32 s67, s48, 15
    s_lshl4_add_u32 s67, s31, s67
    s_mul_i32 s68, s67, 28672
    s_cmp_eq_u32 s2, 255
    s_cbranch_scc0 L_noupd
    s_mov_b32 s66, 8000000
L_w10:
    ds_read_b32 v16, v3 offset:2048
    s_waitcnt lgkmcnt(0)
    v_cmp_ne_u32 vcc, 0, v16
    s_and_b32 s69, vcc_lo, 1
    s_cmp_eq_u32 s69, 1
    s_cbranch_scc1 L_w10_ok
    s_sleep 4
    s_sub_u32 s66, s66, 1
    s_cmp_lg_u32 s66, 0
    s_cbranch_scc1 L_w10
    s_branch L_end
L_w10_ok:
    v_readlane_b32 s50, v16, 1
    v_lshlrev_b32 v14, 4, v0
    s_mov_b32 s64, 4096
    s_mov_b32 s66, 1000000
L_upd_poll:
    buffer_load_dwordx4 v[20:23], v14, s[40:43], s64 offen offset:0 sc1
    buffer_load_dwordx4 v[24:27], v14, s[40:43], s64 offen offset:1024 sc1
    s_waitcnt vmcnt(0)
    v_xor_b32 v16, s50, v21
    v_bitop3_b32 v16, v16, v23, s50 bitop3:0xf6
    v_bitop3_b32 v16, v16, v25, s50 bitop3:0xf6
    v_bitop3_b32 v16, v16, v27, s50 bitop3:0xf6
    v_cmp_ne_u32 vcc, 0, v16
    s_cmp_eq_u64 vcc, 0
    s_cbranch_scc1 L_upd_ok
    s_sleep 16
    s_sub_u32 s66, s66, 1
    s_cmp_lg_u32 s66, 0
    s_cbranch_scc1 L_upd_poll
    s_branch L_end
L_upd_ok:
    v_mov_b32 v17, s50
    s_mov_b64 exec, 1
    buffer_store_dword v17, v10, s[40:43], 0 offen offset:0 sc1
    s_mov_b64 exec, -1
L_noupd:
    s_mov_b32 s66, 8000000
L_w11:
    ds_read_b32 v16, v3 offset:2136
    s_waitcnt lgkmcnt(0)
    v_cmp_ne_u32 vcc, 0, v16
    s_and_b32 s69, vcc_lo, 1023
    s_cmp_eq_u32 s69, 1023
    s_cbranch_scc1 L_w11_ok
    s_sleep 2
    s_sub_u32 s66, s66, 1
    s_cmp_lg_u32 s66, 0
    s_cbranch_scc1 L_w11
    s_branch L_end
L_w11_ok:
    s_mov_b32 m0, 24576
    s_nop 0
    buffer_load_dwordx4 v8, s[44:47], s68 offen offset:0 nt lds
    s_mov_b32 m0, 24704
    s_nop 0
    buffer_load_dwordx4 v8, s[44:47], s68 offen offset:896 nt lds
    s_mov_b32 m0, 24832
    s_nop 0
    buffer_load_dwordx4 v8, s[44:47], s68 offen offset:1792 nt lds
    s_mov_b32 m0, 24960
    s_nop 0
    buffer_load_dwordx4 v8, s[44:47], s68 offen offset:2688 nt lds
    s_mov_b32 m0, 28544
    s_nop 0
    buffer_load_dwordx4 v8, s[44:47], s68 offen offset:128 nt lds
    s_mov_b32 m0, 28672
    s_nop 0
    buffer_load_dwordx4 v8, s[44:47], s68 offen offset:1024 nt lds
    s_mov_b32 m0, 28800
    s_nop 0
    buffer_load_dwordx4 v8, s[44:47], s68 offen offset:1920 nt lds
    s_mov_b32 m0, 28928
    s_nop 0
    buffer_load_dwordx4 v8, s[44:47], s68 offen offset:2816 nt lds
    s_mov_b32 m0, 32512
    s_nop 0
    buffer_load_dwordx4 v8, s[44:47], s68 offen offset:256 nt lds
    s_mov_b32 m0, 32640
    s_nop 0
    buffer_load_dwordx4 v8, s[44:47], s68 offen offset:1152 nt lds
    s_mov_b32 m0, 32768
    s_nop 0
    buffer_load_dwordx4 v8, s[44:47], s68 offen offset:2048 nt lds
    s_mov_b32 m0, 32896
    s_nop 0
    buffer_load_dwordx4 v8, s[44:47], s68 offen offset:2944 nt lds
    s_mov_b32 m0, 36480
    s_nop 0
    buffer_load_dwordx4 v8, s[44:47], s68 offen offset:384 nt lds
    s_mov_b32 m0, 36608
    s_nop 0
    buffer_load_dwordx4 v8, s[44:47], s68 offen offset:1280 nt lds
    s_mov_b32 m0, 36736
    s_nop 0
    buffer_load_dwordx4 v8, s[44:47], s68 offen offset:2176 nt lds
    s_mov_b32 m0, 36864
    s_nop 0
    buffer_load_dwordx4 v8, s[44:47], s68 offen offset:3072 nt lds
    s_mov_b32 m0, 40448
    s_nop 0
    buffer_load_dwordx4 v8, s[44:47], s68 offen offset:512 nt lds
    s_mov_b32 m0, 40576
    s_nop 0
    buffer_load_dwordx4 v8, s[44:47], s68 offen offset:1408 nt lds
    s_mov_b32 m0, 40704
    s_nop 0
    buffer_load_dwordx4 v8, s[44:47], s68 offen offset:2304 nt lds
    s_mov_b32 m0, 40832
    s_nop 0
    buffer_load_dwordx4 v8, s[44:47], s68 offen offset:3200 nt lds
    s_mov_b32 m0, 44416
    s_nop 0
    buffer_load_dwordx4 v8, s[44:47], s68 offen offset:640 nt lds
    s_mov_b32 m0, 44544
    s_nop 0
    buffer_load_dwordx4 v8, s[44:47], s68 offen offset:1536 nt lds
    s_mov_b32 m0, 44672
    s_nop 0
    buffer_load_dwordx4 v8, s[44:47], s68 offen offset:2432 nt lds
    s_mov_b32 m0, 44800
    s_nop 0
    buffer_load_dwordx4 v8, s[44:47], s68 offen offset:3328 nt lds
    s_mov_b32 m0, 48384
    s_nop 0
    buffer_load_dwordx4 v8, s[44:47], s68 offen offset:768 nt lds
    s_mov_b32 m0, 48512
    s_nop 0
    buffer_load_dwordx4 v8, s[44:47], s68 offen offset:1664 nt lds
    s_mov_b32 m0, 48640
    s_nop 0
    buffer_load_dwordx4 v8, s[44:47], s68 offen offset:2560 nt lds
    s_mov_b32 m0, 48768
    s_nop 0
    buffer_load_dwordx4 v8, s[44:47], s68 offen offset:3456 nt lds
    s_waitcnt vmcnt(0)
    s_endpgm
L_helper:
    s_setprio 3
    v_mov_b32 v10, 0
    v_lshlrev_b32 v15, 3, v0
    v_lshrrev_b32 v1, 4, v0
    v_and_b32 v2, 15, v0
    v_and_b32 v13, 7, v0
    v_lshlrev_b32 v3, 2, v2
    v_lshrrev_b32 v11, 5, v0
    s_lshr_b32 s52, s48, 4
    s_and_b32 s90, s2, 1
    s_lshr_b32 s92, s31, 1
    s_add_u32 s92, s92, s48
    s_and_b32 s92, s92, 3
    s_and_b32 s56, s48, 15
    s_lshl2_add_u32 s92, s56, s92
    s_lshr_b32 s3, s48, 0
    s_cmp_ge_u32 s48, 26
    s_cselect_b32 s62, 1, 0
    s_getreg_b32 s94, hwreg(HW_REG_XCC_ID, 0, 4)
    s_lshl_b32 s89, s31, 8
    s_add_u32 s89, s89, 4096
    v_and_b32 v54, 31, v0
    v_lshlrev_b32 v54, 3, v54
    v_mov_b32 v53, 0xff
    s_lshr_b32 s56, s92, 3
    s_lshl3_add_u32 s95, s52, s56
    s_lshl1_add_u32 s95, s95, s90
    s_and_b32 s56, s92, 7
    s_lshl3_add_u32 s95, s95, s56
    s_lshl_b32 s95, s95, 8
    s_add_u32 s95, s95, 65536
    v_and_b32 v23, 1, v1
    v_lshlrev_b32 v12, 5, v13
    v_lshl_add_u32 v12, v23, 4, v12
    v_lshl_add_u32 v12, v11, 3, v12
    v_add_u32 v12, s95, v12
    s_lshl3_add_u32 s56, s48, s89
    v_writelane_b32 v12, s56, 8
    s_mov_b32 s60, 0x00ff01ff
    s_mov_b32 s61, 0x00ff00ff
    s_mov_b32 s66, 8000000
L_w12:
    ds_read_b32 v16, v3 offset:2068
    s_waitcnt lgkmcnt(0)
    v_cmp_ne_u32 vcc, 0, v16
    s_and_b32 s69, vcc_lo, 127
    s_cmp_eq_u32 s69, 127
    s_cbranch_scc1 L_w12_ok
    s_sub_u32 s66, s66, 1
    s_cmp_lg_u32 s66, 0
    s_cbranch_scc1 L_w12
    s_branch L_end
L_w12_ok:
    ds_read_b64 v[24:25], v15 offset:4096
    ds_read_b64 v[26:27], v15 offset:4608
    ds_read_b64 v[28:29], v15 offset:5120
    ds_read_b64 v[30:31], v15 offset:5632
    ds_read_b64 v[32:33], v15 offset:6144
    ds_read_b64 v[34:35], v15 offset:6656
    ds_read_b64 v[36:37], v15 offset:7168
    s_mov_b32 s40, s28
    s_mov_b32 s41, s29
    s_mov_b32 s42, 0x10000000
    s_mov_b32 s43, 0x20000
    s_and_b32 s51, s50, 0x80808080
    s_and_b32 s50, s50, 0x7f7f7f7f
    s_add_u32 s50, s50, 0x2b6d355b
    s_xor_b32 s50, s50, s51
    s_and_b32 s86, s50, 0xff
    s_xor_b32 s87, s86, 0xa5
    v_mul_u32_u24 v20, 0xa5, v11
    v_xor_b32 v20, s86, v20
    s_waitcnt lgkmcnt(0)
    v_pk_add_f32 v[24:25], v[24:25], v[26:27]
    v_pk_add_f32 v[28:29], v[28:29], v[30:31]
    v_pk_add_f32 v[32:33], v[32:33], v[34:35]
    v_pk_add_f32 v[24:25], v[24:25], v[36:37]
    v_pk_add_f32 v[28:29], v[28:29], v[32:33]
    v_pk_add_f32 v[18:19], v[24:25], v[28:29]
    v_bfi_b32 v18, v53, v20, v18
    v_writelane_b32 v18, s94, 8
    v_writelane_b32 v19, s50, 8
    s_mov_b64 exec, s[60:61]
    buffer_store_dwordx2 v[18:19], v12, s[40:43], 0 offen sc1
    s_mov_b64 exec, -1
    ds_write_b32 v10, v53 offset:2064
    v_lshlrev_b32 v14, 4, v0
    s_bfe_u32 s53, s48, 0x10003
    s_cmp_eq_u32 s52, 0
    s_cselect_b32 s59, 25, 6
    s_cselect_b32 s56, 0, 26
    s_mul_i32 s64, s31, 40
    s_add_u32 s64, s64, s56
    s_and_b32 s56, s48, 15
    s_lshl4_add_u32 s64, s64, s56
    s_lshl_b32 s64, s64, 7
    s_add_u32 s64, s64, 131072
    s_lshl_b32 s93, s31, 11
    s_add_u32 s93, s93, 8192
    s_lshr_b32 s65, s48, 3
    s_lshl_b32 s65, s65, 9
    s_add_u32 s65, s65, s93
    v_lshlrev_b32 v9, 4, v13
    v_lshrrev_b32 v22, 3, v0
    v_mov_b32 v41, 0xff800000
    v_add_u32 v40, 0, v22
    v_cmp_lt_u32 vcc, s59, v40
    v_min_u32 v40, s59, v40
    v_lshl_add_u32 v24, v40, 11, v9
    v_cndmask_b32 v32, 0, v41, vcc
    v_lshlrev_b32 v28, 4, v40
    v_add_u32 v40, 8, v22
    v_cmp_lt_u32 vcc, s59, v40
    v_min_u32 v40, s59, v40
    v_lshl_add_u32 v25, v40, 11, v9
    v_cndmask_b32 v33, 0, v41, vcc
    v_lshlrev_b32 v29, 4, v40
    v_add_u32 v40, 16, v22
    v_cmp_lt_u32 vcc, s59, v40
    v_min_u32 v40, s59, v40
    v_lshl_add_u32 v26, v40, 11, v9
    v_cndmask_b32 v34, 0, v41, vcc
    v_lshlrev_b32 v30, 4, v40
    v_add_u32 v40, 24, v22
    v_cmp_lt_u32 vcc, s59, v40
    v_min_u32 v40, s59, v40
    v_lshl_add_u32 v27, v40, 11, v9
    v_cndmask_b32 v35, 0, v41, vcc
    v_lshlrev_b32 v31, 4, v40
    v_lshl_add_u32 v52, v1, 2, v9
    s_lshl3_add_u32 s55, s62, s31
    s_lshl_b32 s55, s55, 12
    s_add_u32 s55, s55, 65536
    s_add_u32 s90, s55, 32768
    s_mov_b32 s66, 8000000
L_w13:
    ds_read_b32 v16, v3 offset:2096
    s_waitcnt lgkmcnt(0)
    v_cmp_ne_u32 vcc, 0, v16
    s_and_b32 s69, vcc_lo, 255
    s_cmp_eq_u32 s69, 255
    s_cbranch_scc1 L_w13_ok
    s_sleep 1
    s_sub_u32 s66, s66, 1
    s_cmp_lg_u32 s66, 0
    s_cbranch_scc1 L_w13
    s_branch L_end
L_w13_ok:
    s_mov_b32 s66, 1000000
L_q_poll:
    s_cmp_eq_u32 s3, 25
    s_cbranch_scc0 L_q_one
    buffer_load_dwordx4 v[72:75], v14, s[40:43], s90 offen offset:0 sc1
    buffer_load_dwordx4 v[76:79], v14, s[40:43], s90 offen offset:1024 sc1
    buffer_load_dwordx4 v[80:83], v14, s[40:43], s90 offen offset:2048 sc1
    buffer_load_dwordx4 v[84:87], v14, s[40:43], s90 offen offset:3072 sc1
L_q_one:
    buffer_load_dwordx4 v[56:59], v14, s[40:43], s55 offen offset:0 sc1
    buffer_load_dwordx4 v[60:63], v14, s[40:43], s55 offen offset:1024 sc1
    buffer_load_dwordx4 v[64:67], v14, s[40:43], s55 offen offset:2048 sc1
    buffer_load_dwordx4 v[68:71], v14, s[40:43], s55 offen offset:3072 sc1
    buffer_load_dwordx2 v[88:89], v54, s[40:43], s89 offen sc1
    s_waitcnt vmcnt(0)
    v_xor_b32 v56, s86, v56
    v_xor_b32 v58, s87, v58
    v_xor_b32 v60, s86, v60
    v_xor_b32 v62, s87, v62
    v_xor_b32 v64, s86, v64
    v_xor_b32 v66, s87, v66
    v_xor_b32 v68, s86, v68
    v_xor_b32 v70, s87, v70
    v_or3_b32 v16, v56, v58, v60
    v_or3_b32 v16, v16, v62, v64
    v_or3_b32 v16, v16, v66, v68
    v_or_b32 v16, v16, v70
    v_and_b32 v16, 0xff, v16
    s_cbranch_scc0 L_q_chk
    v_xor_b32 v72, s86, v72
    v_xor_b32 v74, s87, v74
    v_xor_b32 v76, s86, v76
    v_xor_b32 v78, s87, v78
    v_xor_b32 v80, s86, v80
    v_xor_b32 v82, s87, v82
    v_xor_b32 v84, s86, v84
    v_xor_b32 v86, s87, v86
    v_or3_b32 v16, v16, v72, v74
    v_or3_b32 v16, v16, v76, v78
    v_or3_b32 v16, v16, v80, v82
    v_or3_b32 v16, v16, v84, v86
    v_and_b32 v16, 0xff, v16
L_q_chk:
    v_bitop3_b32 v16, v16, v89, s50 bitop3:0xf6
    v_cmp_ne_u32 vcc, 0, v16
    s_cmp_eq_u64 vcc, 0
    s_cbranch_scc1 L_q_ok
    s_sleep 8
    s_sub_u32 s66, s66, 1
    s_cmp_lg_u32 s66, 0
    s_cbranch_scc1 L_q_poll
    s_branch L_end
L_q_ok:
    s_lshl_b32 s55, s62, 10
    v_add_u32 v16, s55, v15
    v_pk_add_f32 v[56:57], v[56:57], v[64:65]
    v_pk_add_f32 v[58:59], v[58:59], v[66:67]
    v_cvt_pk_bf16_f32 v56, v56, v57
    v_cvt_pk_bf16_f32 v57, v58, v59
    ds_write_b64 v16, v[56:57] offset:0
    v_pk_add_f32 v[60:61], v[60:61], v[68:69]
    v_pk_add_f32 v[62:63], v[62:63], v[70:71]
    v_cvt_pk_bf16_f32 v60, v60, v61
    v_cvt_pk_bf16_f32 v61, v62, v63
    ds_write_b64 v16, v[60:61] offset:512
    s_cmp_eq_u32 s3, 25
    s_cbranch_scc0 L_q_done
    v_pk_add_f32 v[72:73], v[72:73], v[80:81]
    v_pk_add_f32 v[74:75], v[74:75], v[82:83]
    v_cvt_pk_bf16_f32 v72, v72, v73
    v_cvt_pk_bf16_f32 v73, v74, v75
    ds_write_b64 v16, v[72:73] offset:1024
    v_pk_add_f32 v[76:77], v[76:77], v[84:85]
    v_pk_add_f32 v[78:79], v[78:79], v[86:87]
    v_cvt_pk_bf16_f32 v76, v76, v77
    v_cvt_pk_bf16_f32 v77, v78, v79
    ds_write_b64 v16, v[76:77] offset:1536
L_q_done:
    v_cmp_ne_u32 vcc, s94, v88
    s_cmp_eq_u64 vcc, 0
    s_cselect_b32 s88, 1, 0
    v_mov_b32 v16, 1
    v_mov_b32 v17, s50
    v_mov_b32 v18, s88
    ds_write_b128 v10, v[16:19] offset:2048
    s_lshl_b32 s91, s2, 12
    s_add_u32 s91, s91, 1048576
    s_mov_b32 s44, s24
    s_mov_b32 s45, s25
    s_mov_b32 s46, 1792
    s_mov_b32 s47, 0x20000
    s_mov_b32 s56, 0x3db8aa3b
    s_lshl_b32 s63, s62, 7
    v_lshl_add_u32 v10, v1, 6, s63
    v_and_b32 v10, 0xff, v10
    s_mul_i32 s63, s62, 25
    s_sub_u32 s63, s48, s63
    s_lshl_b32 s63, s63, 4
    v_mov_b32 v20, s63
    s_sub_u32 s63, s63, 400
    v_mov_b32 v21, s63
    v_cmp_gt_u32 vcc, 32, v0
    v_lshlrev_b32 v22, 3, v10
    v_and_b32 v12, 1, v0
    v_cndmask_b32 v20, v21, v20, vcc
    v_add_u32 v22, v22, v20
    v_lshlrev_b32 v12, 3, v12
    v_lshl_add_u32 v12, v1, 1, v12
    v_mov_b32 v37, s50
    v_mov_b32 v39, s50
    s_mov_b32 s66, 8000000
L_w14:
    ds_read_b32 v16, v3 offset:2176
    s_waitcnt lgkmcnt(0)
    v_cmp_ne_u32 vcc, 0, v16
    s_and_b32 s69, vcc_lo, 1023
    s_cmp_eq_u32 s69, 1023
    s_cbranch_scc1 L_w14_ok
    s_sleep 1
    s_sub_u32 s66, s66, 1
    s_cmp_lg_u32 s66, 0
    s_cbranch_scc1 L_w14
    s_branch L_end
L_w14_ok:
    ds_read_b128 v[40:43], v10 offset:2560
    ds_read_b128 v[44:47], v10 offset:2576
    ds_read_b64 v[48:49], v10 offset:2592
    ds_read_b128 v[132:135], v10 offset:2304
    ds_read_b128 v[136:139], v10 offset:2320
    ds_read_b64 v[140:141], v10 offset:2336
    s_waitcnt lgkmcnt(3)
    v_max3_f32 v16, v40, v41, v42
    v_max3_f32 v17, v43, v44, v45
    v_max3_f32 v18, v46, v47, v48
    v_max3_f32 v16, v16, v17, v49
    v_max_f32 v36, v16, v18
    v_mul_f32 v20, s56, v36
    v_fma_f32 v40, v40, s56, -v20
    v_fma_f32 v41, v41, s56, -v20
    v_fma_f32 v42, v42, s56, -v20
    v_fma_f32 v43, v43, s56, -v20
    v_fma_f32 v44, v44, s56, -v20
    v_fma_f32 v45, v45, s56, -v20
    v_fma_f32 v46, v46, s56, -v20
    v_fma_f32 v47, v47, s56, -v20
    v_fma_f32 v48, v48, s56, -v20
    v_fma_f32 v49, v49, s56, -v20
    v_exp_f32 v40, v40
    v_exp_f32 v41, v41
    v_exp_f32 v42, v42
    v_exp_f32 v43, v43
    v_exp_f32 v44, v44
    v_exp_f32 v45, v45
    v_exp_f32 v46, v46
    v_exp_f32 v47, v47
    v_exp_f32 v48, v48
    v_exp_f32 v49, v49
    s_waitcnt lgkmcnt(0)
    v_mul_f32 v38, v40, v132
    v_fmac_f32 v38, v41, v133
    v_fmac_f32 v38, v42, v134
    v_fmac_f32 v38, v43, v135
    v_fmac_f32 v38, v44, v136
    v_fmac_f32 v38, v45, v137
    v_fmac_f32 v38, v46, v138
    v_fmac_f32 v38, v47, v139
    v_fmac_f32 v38, v48, v140
    v_fmac_f32 v38, v49, v141
    s_cmp_eq_u32 s3, 25
    s_mov_b32 exec_lo, 0x00010001
    s_cselect_b32 exec_hi, exec_lo, 0
    s_cmp_eq_u32 s88, 0
    s_cbranch_scc1 L_p15_s
    buffer_store_dwordx4 v[36:39], v22, s[40:43], s93 offen
    s_branch L_p15_e
L_p15_s:
    buffer_store_dwordx4 v[36:39], v22, s[40:43], s93 offen sc1
L_p15_e:
    s_mov_b64 exec, -1
    s_mov_b32 s66, 1000000
L_m_poll:
    buffer_load_dwordx4 v[112:115], v28, s[40:43], s65 offen sc1
    buffer_load_dwordx4 v[116:119], v29, s[40:43], s65 offen sc1
    buffer_load_dwordx4 v[120:123], v30, s[40:43], s65 offen sc1
    buffer_load_dwordx4 v[124:127], v31, s[40:43], s65 offen sc1
    buffer_load_dwordx4 v[96:99], v24, s[40:43], s64 offen sc1
    buffer_load_dwordx4 v[100:103], v25, s[40:43], s64 offen sc1
    buffer_load_dwordx4 v[104:107], v26, s[40:43], s64 offen sc1
    buffer_load_dwordx4 v[108:111], v27, s[40:43], s64 offen sc1
    s_waitcnt vmcnt(4)
    v_xor_b32 v16, s50, v113
    v_bitop3_b32 v16, v16, v115, s50 bitop3:0xf6
    v_bitop3_b32 v16, v16, v117, s50 bitop3:0xf6
    v_bitop3_b32 v16, v16, v119, s50 bitop3:0xf6
    v_bitop3_b32 v16, v16, v121, s50 bitop3:0xf6
    v_bitop3_b32 v16, v16, v123, s50 bitop3:0xf6
    v_bitop3_b32 v16, v16, v125, s50 bitop3:0xf6
    v_bitop3_b32 v16, v16, v127, s50 bitop3:0xf6
    v_cmp_ne_u32 vcc, 0, v16
    s_cmp_eq_u64 vcc, 0
    s_cbranch_scc1 L_m_ok
    s_sub_u32 s66, s66, 1
    s_cmp_lg_u32 s66, 0
    s_cbranch_scc1 L_m_poll
    s_branch L_end
L_m_ok:
    buffer_load_dwordx4 v[56:59], v24, s[40:43], s64 offen sc1
    buffer_load_dwordx4 v[60:63], v25, s[40:43], s64 offen sc1
    buffer_load_dwordx4 v[64:67], v26, s[40:43], s64 offen sc1
    buffer_load_dwordx4 v[68:71], v27, s[40:43], s64 offen sc1
    v_add_f32 v112, v112, v32
    v_add_f32 v116, v116, v33
    v_add_f32 v120, v120, v34
    v_add_f32 v124, v124, v35
    v_max3_f32 v17, v112, v116, v120
    v_max_f32 v17, v17, v124
    s_nop 1
    v_max_f32_dpp v17, v17, v17 row_ror:8 row_mask:0xf bank_mask:0xf
    v_mov_b32 v18, v17
    s_nop 1
    v_permlane32_swap_b32 v17, v18
    v_max_f32 v17, v17, v18
    v_mov_b32 v18, v17
    s_nop 1
    v_permlane16_swap_b32 v17, v18
    v_max_f32 v17, v17, v18
    v_mul_f32 v17, s56, v17
    v_fma_f32 v112, v112, s56, -v17
    v_fma_f32 v116, v116, s56, -v17
    v_fma_f32 v120, v120, s56, -v17
    v_fma_f32 v124, v124, s56, -v17
    v_exp_f32 v112, v112
    v_exp_f32 v116, v116
    v_exp_f32 v120, v120
    v_exp_f32 v124, v124
    s_nop 0
    v_mul_f32 v20, v112, v114
    v_fmac_f32 v20, v116, v118
    v_fmac_f32 v20, v120, v122
    v_fmac_f32 v20, v124, v126
    v_mov_b32 v113, v112
    v_mov_b32 v117, v116
    v_add_f32_dpp v20, v20, v20 row_ror:8 row_mask:0xf bank_mask:0xf
    v_mov_b32 v121, v120
    v_mov_b32 v125, v124
    v_mov_b32 v21, v20
    s_nop 1
    v_permlane32_swap_b32 v20, v21
    v_add_f32 v20, v20, v21
    v_mov_b32 v21, v20
    s_nop 1
    v_permlane16_swap_b32 v20, v21
    v_add_f32 v20, v20, v21
    v_rcp_f32 v20, v20
    s_mov_b32 s66, 1000000
L_c_poll:
    s_waitcnt vmcnt(4)
    v_xor_b32 v96, s86, v96
    v_xor_b32 v98, s87, v98
    v_xor_b32 v100, s86, v100
    v_xor_b32 v102, s87, v102
    v_xor_b32 v104, s86, v104
    v_xor_b32 v106, s87, v106
    v_xor_b32 v108, s86, v108
    v_xor_b32 v110, s87, v110
    v_or3_b32 v16, v96, v98, v100
    v_or3_b32 v16, v16, v102, v104
    v_or3_b32 v16, v16, v106, v108
    v_or_b32 v16, v16, v110
    v_and_b32 v16, 0xff, v16
    v_cmp_ne_u32 vcc, 0, v16
    s_cmp_eq_u64 vcc, 0
    s_cbranch_scc1 L_c_ok
    buffer_load_dwordx4 v[72:75], v24, s[40:43], s64 offen sc1
    buffer_load_dwordx4 v[76:79], v25, s[40:43], s64 offen sc1
    buffer_load_dwordx4 v[80:83], v26, s[40:43], s64 offen sc1
    buffer_load_dwordx4 v[84:87], v27, s[40:43], s64 offen sc1
    s_waitcnt vmcnt(4)
    v_xor_b32 v56, s86, v56
    v_xor_b32 v58, s87, v58
    v_xor_b32 v60, s86, v60
    v_xor_b32 v62, s87, v62
    v_xor_b32 v64, s86, v64
    v_xor_b32 v66, s87, v66
    v_xor_b32 v68, s86, v68
    v_xor_b32 v70, s87, v70
    v_or3_b32 v16, v56, v58, v60
    v_or3_b32 v16, v16, v62, v64
    v_or3_b32 v16, v16, v66, v68
    v_or_b32 v16, v16, v70
    v_and_b32 v16, 0xff, v16
    v_cmp_ne_u32 vcc, 0, v16
    s_cmp_eq_u64 vcc, 0
    s_cbranch_scc1 L_c_ok2
    buffer_load_dwordx4 v[96:99], v24, s[40:43], s64 offen sc1
    buffer_load_dwordx4 v[100:103], v25, s[40:43], s64 offen sc1
    buffer_load_dwordx4 v[104:107], v26, s[40:43], s64 offen sc1
    buffer_load_dwordx4 v[108:111], v27, s[40:43], s64 offen sc1
    s_waitcnt vmcnt(4)
    v_xor_b32 v72, s86, v72
    v_xor_b32 v74, s87, v74
    v_xor_b32 v76, s86, v76
    v_xor_b32 v78, s87, v78
    v_xor_b32 v80, s86, v80
    v_xor_b32 v82, s87, v82
    v_xor_b32 v84, s86, v84
    v_xor_b32 v86, s87, v86
    v_or3_b32 v16, v72, v74, v76
    v_or3_b32 v16, v16, v78, v80
    v_or3_b32 v16, v16, v82, v84
    v_or_b32 v16, v16, v86
    v_and_b32 v16, 0xff, v16
    v_cmp_ne_u32 vcc, 0, v16
    s_cmp_eq_u64 vcc, 0
    s_cbranch_scc1 L_c_ok3
    buffer_load_dwordx4 v[56:59], v24, s[40:43], s64 offen sc1
    buffer_load_dwordx4 v[60:63], v25, s[40:43], s64 offen sc1
    buffer_load_dwordx4 v[64:67], v26, s[40:43], s64 offen sc1
    buffer_load_dwordx4 v[68:71], v27, s[40:43], s64 offen sc1
    s_sub_u32 s66, s66, 1
    s_cmp_lg_u32 s66, 0
    s_cbranch_scc1 L_c_poll
    s_branch L_end
L_c_ok2:
    v_pk_mul_f32 v[40:41], v[56:57], v[112:113]
    v_pk_mul_f32 v[42:43], v[58:59], v[112:113]
    v_pk_fma_f32 v[40:41], v[60:61], v[116:117], v[40:41]
    v_pk_fma_f32 v[42:43], v[62:63], v[116:117], v[42:43]
    v_pk_fma_f32 v[40:41], v[64:65], v[120:121], v[40:41]
    v_pk_fma_f32 v[42:43], v[66:67], v[120:121], v[42:43]
    v_pk_fma_f32 v[40:41], v[68:69], v[124:125], v[40:41]
    v_pk_fma_f32 v[42:43], v[70:71], v[124:125], v[42:43]
    s_branch L_c_j
L_c_ok3:
    v_pk_mul_f32 v[40:41], v[72:73], v[112:113]
    v_pk_mul_f32 v[42:43], v[74:75], v[112:113]
    v_pk_fma_f32 v[40:41], v[76:77], v[116:117], v[40:41]
    v_pk_fma_f32 v[42:43], v[78:79], v[116:117], v[42:43]
    v_pk_fma_f32 v[40:41], v[80:81], v[120:121], v[40:41]
    v_pk_fma_f32 v[42:43], v[82:83], v[120:121], v[42:43]
    v_pk_fma_f32 v[40:41], v[84:85], v[124:125], v[40:41]
    v_pk_fma_f32 v[42:43], v[86:87], v[124:125], v[42:43]
    s_branch L_c_j
L_c_ok:
    v_pk_mul_f32 v[40:41], v[96:97], v[112:113]
    v_pk_mul_f32 v[42:43], v[98:99], v[112:113]
    v_pk_fma_f32 v[40:41], v[100:101], v[116:117], v[40:41]
    v_pk_fma_f32 v[42:43], v[102:103], v[116:117], v[42:43]
    v_pk_fma_f32 v[40:41], v[104:105], v[120:121], v[40:41]
    v_pk_fma_f32 v[42:43], v[106:107], v[120:121], v[42:43]
    v_pk_fma_f32 v[40:41], v[108:109], v[124:125], v[40:41]
    v_pk_fma_f32 v[42:43], v[110:111], v[124:125], v[42:43]
    s_nop 0
L_c_j:
    s_nop 0
    v_permlane32_swap_b32 v40, v42
    v_permlane32_swap_b32 v41, v43
    v_add_f32 v40, v40, v42
    v_add_f32 v41, v41, v43
    s_nop 1
    v_permlane16_swap_b32 v40, v41
    v_add_f32 v40, v40, v41
    s_nop 1
    v_add_f32_dpp v40, v40, v40 row_ror:8 row_mask:0xf bank_mask:0xf
    v_mul_f32 v40, v40, v20
    v_cvt_pk_bf16_f32 v40, v40, v40
    ds_write_b32 v52, v40 offset:2816
    s_waitcnt lgkmcnt(0)
    s_barrier
    s_cmp_ge_u32 s2, 112
    s_cbranch_scc1 L_fin
    s_mov_b32 s66, 1000000
    s_lshl_b32 s65, s2, 4
    s_mov_b32 s54, 0x00030003
    s_mov_b32 s55, s54
L_fin_poll:
    buffer_load_dwordx4 v[20:23], v14, s[40:43], s91 offen offset:0 sc1
    buffer_load_dwordx4 v[24:27], v14, s[40:43], s91 offen offset:1024 sc1
    buffer_load_dwordx4 v[28:31], v14, s[40:43], s91 offen offset:2048 sc1
    buffer_load_dwordx4 v[32:35], v14, s[40:43], s91 offen offset:3072 sc1
    s_waitcnt vmcnt(0)
    v_xor_b32 v20, s86, v20
    v_xor_b32 v22, s87, v22
    v_xor_b32 v24, s86, v24
    v_xor_b32 v26, s87, v26
    v_xor_b32 v28, s86, v28
    v_xor_b32 v30, s87, v30
    v_xor_b32 v32, s86, v32
    v_xor_b32 v34, s87, v34
    v_or3_b32 v16, v20, v22, v24
    v_or3_b32 v16, v16, v26, v28
    v_or3_b32 v16, v16, v30, v32
    v_or_b32 v16, v16, v34
    v_and_b32 v16, 0xff, v16
    v_cmp_ne_u32 vcc, 0, v16
    s_cmp_eq_u64 vcc, 0
    s_cbranch_scc1 L_fin_ok
    s_sub_u32 s66, s66, 1
    s_cmp_lg_u32 s66, 0
    s_cbranch_scc1 L_fin_poll
    s_branch L_end
L_fin_ok:
    v_pk_add_f32 v[40:41], v[20:21], v[24:25]
    v_pk_add_f32 v[44:45], v[28:29], v[32:33]
    v_pk_add_f32 v[42:43], v[22:23], v[26:27]
    v_pk_add_f32 v[46:47], v[30:31], v[34:35]
    v_pk_add_f32 v[40:41], v[40:41], v[44:45]
    v_pk_add_f32 v[42:43], v[42:43], v[46:47]
    s_nop 1
    v_permlane32_swap_b32 v40, v42
    v_permlane32_swap_b32 v41, v43
    v_add_f32 v40, v40, v42
    v_add_f32 v41, v41, v43
    s_nop 1
    v_permlane16_swap_b32 v40, v41
    v_add_f32 v40, v40, v41
    s_nop 1
    v_add_f32_dpp v40, v40, v40 row_ror:8 row_mask:0xf bank_mask:0xf
    s_nop 1
    v_add_f32_dpp v40, v40, v40 row_ror:4 row_mask:0xf bank_mask:0xf
    s_nop 1
    v_add_f32_dpp v40, v40, v40 row_ror:2 row_mask:0xf bank_mask:0xf
    v_cvt_pk_bf16_f32 v40, v40, v40
    s_mov_b64 exec, s[54:55]
    buffer_store_short v40, v12, s[44:47], s65 offen
L_fin:
L_end:
    s_endpgm
.section .rodata,"a"
.p2align 6
.amdhsa_kernel concat_heads__gqa_block_cached__sliding_block_cached__decode_kernel
  .amdhsa_next_free_vgpr 168
  .amdhsa_next_free_sgpr 96
  .amdhsa_accum_offset 168
  .amdhsa_group_segment_fixed_size 0
  .amdhsa_kernarg_size 104
  .amdhsa_user_sgpr_count 2
  .amdhsa_user_sgpr_kernarg_segment_ptr 1
  .amdhsa_system_sgpr_workgroup_id_x 1
.end_amdhsa_kernel
```
